```python
import torch

def _softmax(x, axis=-1):
    return torch.softmax(x, dim=axis)
def _gelu(x):
    return torch.nn.functional.gelu(x, approximate="tanh")
def _silu(x):
    return torch.nn.functional.silu(x)
def _sigmoid(x):
    return torch.sigmoid(x)
def _layernorm(x, axis=-1, eps=1e-5):
    m = x.mean(dim=axis, keepdim=True)
    v = x.var(dim=axis, keepdim=True, unbiased=False)
    return (x - m) / torch.sqrt(v + eps)
def _scatter_add(tgt, idx, src, axis=0):
    return tgt.clone().index_add_(axis, idx, src)
def _segment_sum(src, seg, n):
    out = torch.zeros((n,) + src.shape[1:], dtype=src.dtype)
    return out.index_add_(0, seg, src)
def _pad(x, pw):
    flat = tuple(v for pair in reversed(pw) for v in pair)
    return torch.nn.functional.pad(x, flat)

kernel_name = 'sequential_preLN__sliding_block_cached__geglu_ffn__decode'

def setup_inputs():

    _w = (lambda a: (lambda t: t.to(torch.bfloat16) if t.is_floating_point() else t)(torch.as_tensor(a)))
    def _A_setup():
        B, Sq, D = 4, 1, 512
        Hq, Hkv, Sk, Dh = 32, 8, 8192, 128
        assert Hq % Hkv == 0, (Hq, Hkv)
        return {
            "x": _w((lambda *s: torch.randn(*s, dtype=torch.bfloat16) * 0.05)(B, Sq, D)),
            "k_cache": _w((lambda *s: torch.randn(*s, dtype=torch.bfloat16) * 3.2)(B, Hkv, Sk, Dh)),
            "v_cache": _w((lambda *s: torch.randn(*s, dtype=torch.bfloat16) * 0.4)(B, Hkv, Sk, Dh)),
            "wq": _w((lambda *s: torch.randn(*s, dtype=torch.bfloat16) * 3.2)(D, Hq * Dh) * (D ** -0.5)),
            "wo": _w((lambda *s: torch.randn(*s, dtype=torch.bfloat16) * 0.4)(Hq * Dh, D) * ((Hq * Dh) ** -0.5)),
        }
    _A_in = _A_setup()

    def _B_setup():
        B, S, D, F = 4, 1, 512, 1792
        return {
            "x": _w((lambda *s: torch.randn(*s, dtype=torch.bfloat16) * 0.05)(B, S, D)),
            "w_gate": _w((lambda *s: torch.randn(*s, dtype=torch.bfloat16) * 0.05)(D, F)),
            "w_up": _w((lambda *s: torch.randn(*s, dtype=torch.bfloat16) * 0.05)(D, F)),
            "w_down": _w((lambda *s: torch.randn(*s, dtype=torch.bfloat16) * 0.05)(F, D)),
        }
    _B_in = _B_setup()

    return {
        "A_x": _A_in["x"],
        "A_k_cache": _A_in["k_cache"],
        "A_v_cache": _A_in["v_cache"],
        "A_wq": _A_in["wq"],
        "A_wo": _A_in["wo"],
        "B_x": _B_in["x"],
        "B_w_gate": _B_in["w_gate"],
        "B_w_up": _B_in["w_up"],
        "B_w_down": _B_in["w_down"],
    }

def reference(A_x, A_k_cache, A_v_cache, A_wq, A_wo, B_x, B_w_gate, B_w_up, B_w_down):
    def _A_ref(x, k_cache, v_cache, wq, wo):
        B, Sq, D = x.shape
        Hq, Dh = 32, 128
        Hkv, Sk = k_cache.shape[1], k_cache.shape[2]
        W = min(4096, max(256, Sk // 4))
        rep = Hq // Hkv
        q = (lambda x, *d: x.permute(*d))((x @ wq).reshape(B, Sq, Hq, Dh), 0, 2, 1, 3)
        k = (lambda x, n, axis: torch.repeat_interleave(x, n, dim=axis))(k_cache[:, :, Sk - W:, :], rep, axis=1)
        v = (lambda x, n, axis: torch.repeat_interleave(x, n, dim=axis))(v_cache[:, :, Sk - W:, :], rep, axis=1)
        scores = torch.einsum("bhqd,bhkd->bhqk", q, k) * (Dh ** -0.5)
        p = _softmax(scores, axis=-1)
        o = torch.einsum("bhqk,bhkd->bhqd", p, v)
        return (lambda x, *d: x.permute(*d))(o, 0, 2, 1, 3).reshape(B, Sq, Hq * Dh) @ wo

    def _B_ref(x, w_gate, w_up, w_down):
        return (_gelu(x @ w_gate) * (x @ w_up)) @ w_down

    x = A_x
    h = x + _A_ref(_layernorm(x, axis=-1), A_k_cache, A_v_cache, A_wq, A_wo)
    h2 = h + _B_ref(_layernorm(h, axis=-1), B_w_gate, B_w_up, B_w_down)
    return h2
```

```asm
; @launch grid=(256,1,1) block=(640,1,1) lds=163840
.amdgcn_target "amdgcn-amd-amdhsa--gfx950"
.text
.globl sequential_preLN__sliding_block_cached__geglu_ffn__decode_kernel
.p2align 8
.type sequential_preLN__sliding_block_cached__geglu_ffn__decode_kernel,@function
sequential_preLN__sliding_block_cached__geglu_ffn__decode_kernel:
  s_cmp_ge_u32 s2, 256
  s_cbranch_scc1 L_END
  s_load_dwordx16 s[4:19], s[0:1], 0
  s_load_dwordx8 s[20:27], s[0:1], 64
  v_lshrrev_b32 v1, 6, v0
  v_and_b32 v0, 63, v0
  s_and_b32 s28, s2, 7
  v_readfirstlane_b32 s3, v1
  s_lshr_b32 s29, s2, 3
  s_getreg_b32 s30, hwreg(HW_REG_XCC_ID)
  s_lshr_b32 s32, s29, 3
  s_and_b32 s33, s29, 7
  s_lshr_b32 s34, s29, 4
  s_and_b32 s35, s29, 15
  s_and_b32 s30, s30, 15
  s_lshl_b32 s36, s28, 5
  s_add_u32 s36, s36, s29
  s_mov_b32 s44, 0x40000
  v_and_b32 v2, 15, v0
  v_lshrrev_b32 v3, 4, v0
  v_mov_b32 v91, 160768
  s_cmp_eq_u32 s3, 8
  s_cbranch_scc1 L_LOADER
  s_cmp_eq_u32 s3, 9
  s_cbranch_scc1 L_HELPER
  v_mov_b32 v92, 1
  s_lshl_b32 s43, s28, 1
  s_add_u32 s43, s43, s34
  s_and_b32 s37, s35, 1
  s_lshl_b32 s38, s34, 1
  s_add_u32 s38, s38, s37
  s_cmp_lt_u32 s35, 14
  s_cselect_b32 s39, s3, s28
  s_lshl_b32 s40, s38, 10
  s_lshl_b32 s41, s39, 7
  s_add_u32 s40, s40, s41
  v_lshl_add_u32 v4, v2, 2, v3
  v_lshl_add_u32 v4, v4, 1, s40
  s_lshl_b32 s41, s3, 10
  v_lshl_add_u32 v5, v0, 4, s41
  s_waitcnt lgkmcnt(0)
  s_load_dword s31, s[26:27], 0
  global_load_ushort v93, v4, s[4:5]
  s_cmp_ge_u32 s3, 4
  s_cbranch_scc1 L_NOLN0
  global_load_dwordx4 v[10:13], v5, s[4:5]
L_NOLN0:
  s_cmp_lg_u32 s3, 0
  s_cbranch_scc1 L_NOCLR
  v_mov_b32 v20, -1
  v_mov_b32 v21, -1
  v_mov_b32 v22, -1
  v_mov_b32 v23, -1
  s_lshl_b32 s41, s43, 14
  s_lshl_b32 s42, s35, 10
  s_add_u32 s41, s41, s42
  s_add_u32 s41, s41, 262144
  v_lshl_add_u32 v7, v0, 4, s41
  global_store_dwordx4 v7, v[20:23], s[26:27] sc1
  s_lshl_b32 s41, s36, 10
  s_add_u32 s41, s41, 786432
  v_lshl_add_u32 v8, v0, 4, s41
  global_store_dwordx4 v8, v[20:23], s[26:27] sc1
  s_lshl_b32 s41, s43, 8
  s_lshl_b32 s42, s35, 7
  s_add_u32 s41, s41, s42
  s_add_u32 s41, s41, 524288
  s_lshl_b32 s42, s36, 10
  s_add_u32 s42, s42, 786432
  s_cmp_lt_u32 s35, 2
  s_cselect_b32 s41, s41, s42
  v_and_b32 v6, 7, v0
  v_lshl_add_u32 v6, v6, 4, s41
  global_store_dwordx4 v6, v[20:23], s[26:27] sc1
L_NOCLR:
  s_barrier
  s_cmp_ge_u32 s3, 4
  s_cbranch_scc1 L_QSKIP
  s_cmp_eq_u32 s3, 0
  s_cbranch_scc1 L_LNW0
  s_waitcnt vmcnt(0)
  s_branch L_LNW
L_LNW0:
  s_waitcnt vmcnt(3)
L_LNW:
  v_lshlrev_b32 v14, 16, v10
  v_and_b32 v15, 0xffff0000, v10
  v_lshlrev_b32 v16, 16, v11
  v_and_b32 v17, 0xffff0000, v11
  v_lshlrev_b32 v18, 16, v12
  v_and_b32 v19, 0xffff0000, v12
  v_lshlrev_b32 v20, 16, v13
  v_and_b32 v21, 0xffff0000, v13
  v_add_f32 v22, v14, v15
  v_add_f32 v23, v16, v17
  v_add_f32 v24, v18, v19
  v_add_f32 v25, v20, v21
  v_add_f32 v22, v22, v23
  v_add_f32 v24, v24, v25
  v_add_f32 v22, v22, v24
  s_nop 1
  v_add_f32_dpp v22, v22, v22 row_ror:8 row_mask:0xf bank_mask:0xf
  s_nop 1
  v_add_f32_dpp v22, v22, v22 row_ror:4 row_mask:0xf bank_mask:0xf
  s_nop 1
  v_add_f32_dpp v22, v22, v22 row_ror:2 row_mask:0xf bank_mask:0xf
  s_nop 1
  v_add_f32_dpp v22, v22, v22 row_ror:1 row_mask:0xf bank_mask:0xf
  v_mov_b32 v23, v22
  s_nop 1
  v_permlane16_swap_b32 v22, v23
  s_nop 1
  v_add_f32 v22, v22, v23
  v_mov_b32 v23, v22
  s_nop 1
  v_permlane32_swap_b32 v22, v23
  s_nop 1
  v_add_f32 v22, v22, v23
  v_mul_f32 v22, 0x3b000000, v22
  v_sub_f32 v23, v14, v22
  v_mul_f32 v24, v23, v23
  v_sub_f32 v23, v15, v22
  v_fmac_f32 v24, v23, v23
  v_sub_f32 v23, v16, v22
  v_fmac_f32 v24, v23, v23
  v_sub_f32 v23, v17, v22
  v_fmac_f32 v24, v23, v23
  v_sub_f32 v23, v18, v22
  v_fmac_f32 v24, v23, v23
  v_sub_f32 v23, v19, v22
  v_fmac_f32 v24, v23, v23
  v_sub_f32 v23, v20, v22
  v_fmac_f32 v24, v23, v23
  v_sub_f32 v23, v21, v22
  v_fmac_f32 v24, v23, v23
  s_nop 1
  v_add_f32_dpp v24, v24, v24 row_ror:8 row_mask:0xf bank_mask:0xf
  s_nop 1
  v_add_f32_dpp v24, v24, v24 row_ror:4 row_mask:0xf bank_mask:0xf
  s_nop 1
  v_add_f32_dpp v24, v24, v24 row_ror:2 row_mask:0xf bank_mask:0xf
  s_nop 1
  v_add_f32_dpp v24, v24, v24 row_ror:1 row_mask:0xf bank_mask:0xf
  v_mov_b32 v23, v24
  s_nop 1
  v_permlane16_swap_b32 v24, v23
  s_nop 1
  v_add_f32 v24, v24, v23
  v_mov_b32 v23, v24
  s_nop 1
  v_permlane32_swap_b32 v24, v23
  s_nop 1
  v_add_f32 v24, v24, v23
  v_mul_f32 v24, 0x3b000000, v24
  v_cvt_pk_bf16_f32 v22, v22, v22
  v_lshlrev_b32 v22, 16, v22
  v_cvt_pk_bf16_f32 v24, v24, v24
  v_lshlrev_b32 v24, 16, v24
  v_add_f32 v24, 0x3727c5ac, v24
  v_cvt_pk_bf16_f32 v24, v24, v24
  v_lshlrev_b32 v24, 16, v24
  v_sqrt_f32 v24, v24
  s_nop 0
  v_cvt_pk_bf16_f32 v24, v24, v24
  v_lshlrev_b32 v24, 16, v24
  v_rcp_f32 v24, v24
  v_sub_f32 v14, v14, v22
  v_cvt_pk_bf16_f32 v14, v14, v14
  v_lshlrev_b32 v14, 16, v14
  v_mul_f32 v14, v14, v24
  v_sub_f32 v15, v15, v22
  v_cvt_pk_bf16_f32 v15, v15, v15
  v_lshlrev_b32 v15, 16, v15
  v_mul_f32 v15, v15, v24
  v_sub_f32 v16, v16, v22
  v_cvt_pk_bf16_f32 v16, v16, v16
  v_lshlrev_b32 v16, 16, v16
  v_mul_f32 v16, v16, v24
  v_sub_f32 v17, v17, v22
  v_cvt_pk_bf16_f32 v17, v17, v17
  v_lshlrev_b32 v17, 16, v17
  v_mul_f32 v17, v17, v24
  v_sub_f32 v18, v18, v22
  v_cvt_pk_bf16_f32 v18, v18, v18
  v_lshlrev_b32 v18, 16, v18
  v_mul_f32 v18, v18, v24
  v_sub_f32 v19, v19, v22
  v_cvt_pk_bf16_f32 v19, v19, v19
  v_lshlrev_b32 v19, 16, v19
  v_mul_f32 v19, v19, v24
  v_sub_f32 v20, v20, v22
  v_cvt_pk_bf16_f32 v20, v20, v20
  v_lshlrev_b32 v20, 16, v20
  v_mul_f32 v20, v20, v24
  v_sub_f32 v21, v21, v22
  v_cvt_pk_bf16_f32 v21, v21, v21
  v_lshlrev_b32 v21, 16, v21
  v_mul_f32 v21, v21, v24
  v_cvt_pk_bf16_f32 v10, v14, v15
  v_cvt_pk_bf16_f32 v11, v16, v17
  v_cvt_pk_bf16_f32 v12, v18, v19
  v_cvt_pk_bf16_f32 v13, v20, v21
  s_mul_i32 s41, s3, 1088
  s_add_u32 s41, s41, 147456
  v_lshl_add_u32 v6, v0, 4, s41
  ds_write_b128 v6, v[10:13]
  s_mov_b64 exec, 1
  ds_add_u32 v91, v92 offset:4
  s_mov_b64 exec, -1
  v_and_b32 v6, 3, v0
  v_mul_u32_u24 v6, 1088, v6
  v_lshl_add_u32 v6, v3, 4, v6
  s_lshl_b32 s41, s32, 8
  s_add_u32 s41, s41, 147456
  v_add_u32 v6, s41, v6
  v_lshrrev_b32 v7, 2, v2
  v_lshl_add_u32 v8, v3, 3, v7
  v_lshlrev_b32 v8, 7, v8
  v_lshrrev_b32 v7, 1, v7
  v_and_b32 v9, 1, v3
  v_lshl_or_b32 v7, v9, 1, v7
  v_xor_b32 v7, s3, v7
  v_lshl_add_u32 v8, v7, 5, v8
  v_and_b32 v9, 3, v2
  v_lshl_add_u32 v8, v9, 3, v8
  v_add_u32 v7, 131072, v8
  s_lshl_b32 s41, s36, 10
  s_lshl_b32 s42, s3, 6
  s_add_u32 s41, s41, s42
  s_add_u32 s41, s41, 1048576
  v_lshlrev_b32 v98, 8, v3
  v_lshl_add_u32 v98, v2, 2, v98
  v_add_u32 v98, s41, v98
W_1:
  ds_read_b32 v90, v91 offset:4
  s_waitcnt lgkmcnt(0)
  v_readfirstlane_b32 s45, v90
  s_cmp_ge_u32 s45, 4
  s_cbranch_scc1 WD_2
  s_cmp_eq_u32 s44, 0
  s_cbranch_scc1 WD_2
  s_sub_u32 s44, s44, 1
  s_sleep 1
  s_branch W_1
WD_2:
  s_add_u32 s31, s31, 1
  v_and_b32 v80, 3, v0
  v_lshlrev_b32 v90, 3, v80
  v_lshrrev_b32 v90, v90, s31
  v_cmp_eq_u32 vcc, 0, v80
  v_lshlrev_b32 v80, 6, v80
  v_add_u32 v80, s31, v80
  v_cndmask_b32 v90, v90, 0, vcc
  v_add_u32 v80, v80, v90
  v_and_b32 v80, 0xff, v80
W_3:
  ds_read_b32 v90, v91 offset:0
  s_waitcnt lgkmcnt(0)
  v_readfirstlane_b32 s45, v90
  s_cmp_ge_u32 s45, 4
  s_cbranch_scc1 WD_4
  s_cmp_eq_u32 s44, 0
  s_cbranch_scc1 WD_4
  s_sub_u32 s44, s44, 1
  s_sleep 1
  s_branch W_3
WD_4:
  ds_read_b128 v[10:13], v6 offset:0
  ds_read_b64_tr_b16 v[30:31], v7 offset:0
  ds_read_b64_tr_b16 v[32:33], v7 offset:512
  ds_read_b128 v[14:17], v6 offset:64
  ds_read_b64_tr_b16 v[34:35], v7 offset:4096
  ds_read_b64_tr_b16 v[36:37], v7 offset:4608
  ds_read_b128 v[18:21], v6 offset:128
  ds_read_b64_tr_b16 v[38:39], v7 offset:8192
  ds_read_b64_tr_b16 v[40:41], v7 offset:8704
  ds_read_b128 v[22:25], v6 offset:192
  ds_read_b64_tr_b16 v[42:43], v7 offset:12288
  ds_read_b64_tr_b16 v[44:45], v7 offset:12800
  s_waitcnt lgkmcnt(0)
  v_mfma_f32_16x16x32_bf16 v[26:29], v[10:13], v[30:33], 0
  v_mfma_f32_16x16x32_bf16 v[26:29], v[14:17], v[34:37], v[26:29]
  v_mfma_f32_16x16x32_bf16 v[26:29], v[18:21], v[38:41], v[26:29]
  v_mfma_f32_16x16x32_bf16 v[26:29], v[22:25], v[42:45], v[26:29]
  v_cmp_eq_u32 vcc, 1, v3
  v_cmp_eq_u32 s[46:47], 2, v3
  v_cmp_eq_u32 s[48:49], 3, v3
  s_add_u32 s52, s26, 524288
  s_addc_u32 s53, s27, 0
  s_nop 3
  v_cndmask_b32 v26, v26, v27, vcc
  v_cndmask_b32 v26, v26, v28, s[46:47]
  v_cndmask_b32 v26, v26, v29, s[48:49]
  s_mov_b32 s46, 0xffffff00
  v_add_u32 v26, 0x80, v26
  v_bfi_b32 v26, s46, v26, v80
  s_cmp_eq_u32 s3, 0
  s_cbranch_scc0 L_QW123
  s_waitcnt vmcnt(0)
  ds_write_b32 v91, v92 offset:20
  s_branch L_QST
L_QW123:
W_5:
  ds_read_b32 v90, v91 offset:20
  s_waitcnt lgkmcnt(0)
  v_readfirstlane_b32 s45, v90
  s_cmp_ge_u32 s45, 1
  s_cbranch_scc1 WD_6
  s_cmp_eq_u32 s44, 0
  s_cbranch_scc1 WD_6
  s_sub_u32 s44, s44, 1
  s_branch W_5
WD_6:
L_QST:
  v_mov_b32 v99, v26
  s_and_b32 s41, s31, 0xffffff
  s_lshl_b32 s41, s41, 8
  s_or_b32 s41, s41, s30
  v_mov_b32 v112, s41
  s_lshl_b32 s41, s28, 7
  s_lshl_b32 s42, s29, 2
  s_add_u32 s41, s41, s42
  s_add_u32 s41, s41, 32768
  v_mov_b32 v113, s41
  s_lshl_b32 s41, s36, 7
  s_add_u32 s41, s41, 65536
  v_mov_b32 v114, s41
  global_store_dword v98, v99, s[26:27]
  s_cmp_eq_u32 s3, 0
  s_cbranch_scc0 L_QST1
  s_mov_b64 exec, 1
  global_store_dword v113, v112, s[26:27]
  s_mov_b64 exec, -1
L_QST1:
  s_mov_b32 s50, 0
  s_cmp_ge_u32 s3, 2
  s_cbranch_scc1 L_QDONE
  v_lshrrev_b32 v12, 4, v0
  s_lshl_b32 s41, s3, 2
  v_add_u32 v12, s41, v12
  v_lshlrev_b32 v12, 10, v12
  v_lshl_add_u32 v12, v2, 4, v12
  s_lshl_b32 s41, s28, 15
  s_lshl_b32 s42, s32, 8
  s_add_u32 s41, s41, s42
  s_add_u32 s41, s41, 1048576
  v_add_u32 v12, s41, v12
  v_add_u32 v13, 8192, v12
  v_add_u32 v14, 16384, v12
  v_add_u32 v15, 24576, v12
  v_and_b32 v37, 31, v0
  s_lshl_b32 s41, s28, 7
  s_add_u32 s41, s41, 32768
  v_lshl_add_u32 v38, v37, 2, s41
  s_lshl_b32 s41, s28, 12
  s_add_u32 s41, s41, 65536
  v_lshl_add_u32 v39, v37, 7, s41
  s_and_b32 s46, s31, 0xff
  s_lshr_b32 s47, s31, 8
  s_add_u32 s47, s47, s31
  s_add_u32 s47, s47, 64
  s_and_b32 s47, s47, 0xff
  s_lshr_b32 s48, s31, 16
  s_add_u32 s48, s48, s31
  s_add_u32 s48, s48, 128
  s_and_b32 s48, s48, 0xff
  s_lshr_b32 s49, s31, 24
  s_add_u32 s49, s49, s31
  s_add_u32 s49, s49, 192
  s_and_b32 s49, s49, 0xff
  s_and_b32 s56, s31, 0xffffff
  s_mov_b32 s54, s26
  s_mov_b32 s55, s27
  s_mov_b32 s57, 0
  v_mov_b32 v42, v38
L_QPOLL:
  s_cmp_ge_u32 s57, 41
  s_cselect_b32 s41, s57, 0
  s_bitcmp1_b32 s41, 0
  s_cselect_b32 s54, s52, s26
  s_cselect_b32 s55, s53, s27
  s_cbranch_scc1 L_QUSEB
  v_mov_b32 v38, v42
  s_branch L_QUSE
L_QUSEB:
  v_mov_b32 v38, v39
L_QUSE:
  global_load_dwordx4 v[16:19], v12, s[54:55] sc1
  global_load_dwordx4 v[20:23], v13, s[54:55] sc1
  global_load_dwordx4 v[24:27], v14, s[54:55] sc1
  global_load_dwordx4 v[28:31], v15, s[54:55] sc1
  global_load_dword v40, v38, s[26:27] sc1
  s_waitcnt vmcnt(0)
  v_xor_b32 v32, s46, v16
  v_xor_b32 v33, s46, v20
  v_xor_b32 v34, s46, v24
  v_xor_b32 v35, s46, v28
  v_or3_b32 v32, v32, v33, v34
  v_or_b32 v36, v32, v35
  v_xor_b32 v32, s47, v17
  v_xor_b32 v33, s47, v21
  v_xor_b32 v34, s47, v25
  v_xor_b32 v35, s47, v29
  v_or3_b32 v32, v32, v33, v34
  v_or3_b32 v36, v36, v32, v35
  v_xor_b32 v32, s48, v18
  v_xor_b32 v33, s48, v22
  v_xor_b32 v34, s48, v26
  v_xor_b32 v35, s48, v30
  v_or3_b32 v32, v32, v33, v34
  v_or3_b32 v36, v36, v32, v35
  v_xor_b32 v32, s49, v19
  v_xor_b32 v33, s49, v23
  v_xor_b32 v34, s49, v27
  v_xor_b32 v35, s49, v31
  v_or3_b32 v32, v32, v33, v34
  v_or3_b32 v36, v36, v32, v35
  v_and_b32 v36, 0xff, v36
  v_lshrrev_b32 v41, 8, v40
  v_xor_b32 v41, s56, v41
  v_or_b32 v36, v36, v41
  v_cmp_ne_u32 vcc, 0, v36
  s_cbranch_vccz L_QGOT
  s_add_u32 s57, s57, 1
  s_cmp_eq_u32 s57, 41
  s_cbranch_scc0 L_QRETRY
  v_mov_b32 v10, 1
  ds_write_b32 v91, v10 offset:8
  global_store_dword v98, v99, s[52:53] sc1
  s_cmp_eq_u32 s3, 0
  s_cbranch_scc0 L_QB1
  s_mov_b64 exec, 1
  global_store_dword v114, v112, s[26:27] sc1
  s_mov_b64 exec, -1
L_QB1:
  s_mov_b32 s50, 1
L_QRETRY:
  s_cmp_eq_u32 s44, 0
  s_cbranch_scc1 L_QGOT
  s_sub_u32 s44, s44, 1
  s_branch L_QPOLL
L_QGOT:
  v_and_b32 v41, 0xff, v40
  v_cmp_ne_u32 vcc, s30, v41
  s_cmp_eq_u64 vcc, 0
  s_cselect_b32 s41, 2, 1
  s_cmp_eq_u32 s50, 0
  s_cselect_b32 s41, s41, 1
  s_cmp_eq_u32 s3, 0
  s_cbranch_scc0 L_QNOX
  v_mov_b32 v10, s41
  ds_write_b32 v91, v10 offset:8
L_QNOX:
  v_add_f32 v16, v16, v20
  v_add_f32 v24, v24, v28
  v_add_f32 v17, v17, v21
  v_add_f32 v25, v25, v29
  v_add_f32 v18, v18, v22
  v_add_f32 v26, v26, v30
  v_add_f32 v19, v19, v23
  v_add_f32 v27, v27, v31
  v_add_f32 v16, v16, v24
  v_add_f32 v17, v17, v25
  v_add_f32 v18, v18, v26
  v_add_f32 v19, v19, v27
  v_cvt_pk_bf16_f32 v16, v16, v17
  v_cvt_pk_bf16_f32 v17, v18, v19
  v_lshrrev_b32 v22, 5, v0
  s_lshl_b32 s41, s3, 1
  v_add_u32 v22, s41, v22
  v_mul_u32_u24 v22, 320, v22
  v_and_b32 v23, 31, v0
  v_lshl_add_u32 v22, v23, 3, v22
  v_add_u32 v22, 154112, v22
  ds_write_b64 v22, v[16:17]
  s_mov_b64 exec, 1
  ds_add_u32 v91, v92 offset:12
  s_mov_b64 exec, -1
L_QBCHK:
  s_branch L_QDONE
L_QSKIP:
  s_waitcnt lgkmcnt(0)
  s_mov_b32 s50, 1
  v_mov_b32 v98, 0
  v_mov_b32 v99, 0
  v_mov_b32 v112, 0
  v_mov_b32 v114, 0
  s_add_u32 s52, s26, 524288
  s_addc_u32 s53, s27, 0
  s_waitcnt lgkmcnt(0)
  s_add_u32 s31, s31, 1
  v_and_b32 v80, 3, v0
  v_lshlrev_b32 v90, 3, v80
  v_lshrrev_b32 v90, v90, s31
  v_cmp_eq_u32 vcc, 0, v80
  v_lshlrev_b32 v80, 6, v80
  v_add_u32 v80, s31, v80
  v_cndmask_b32 v90, v90, 0, vcc
  v_add_u32 v80, v80, v90
  v_and_b32 v80, 0xff, v80
L_QDONE:
  v_lshrrev_b32 v6, 2, v2
  v_mul_u32_u24 v6, 320, v6
  v_lshl_add_u32 v6, v3, 4, v6
  v_add_u32 v6, 154112, v6
  v_xor_b32 v7, v3, v2
  v_lshlrev_b32 v7, 4, v7
  v_lshlrev_b32 v8, 8, v2
  s_lshl_b32 s41, s3, 13
  v_add_u32 v8, s41, v8
  v_add_u32 v26, v8, v7
  v_xor_b32 v27, 64, v7
  v_add_u32 v27, v8, v27
  v_xor_b32 v28, 128, v7
  v_add_u32 v28, v8, v28
  v_xor_b32 v29, 192, v7
  v_add_u32 v29, v8, v29
  v_lshrrev_b32 v9, 2, v2
  v_and_b32 v7, 1, v3
  v_lshl_or_b32 v7, v7, 2, v9
  v_lshlrev_b32 v7, 1, v7
  s_lshl_b32 s41, s3, 1
  v_xor_b32 v7, s41, v7
  v_lshlrev_b32 v7, 4, v7
  v_lshl_add_u32 v8, v3, 3, v9
  v_lshl_add_u32 v7, v8, 8, v7
  v_and_b32 v10, 3, v2
  v_lshl_add_u32 v7, v10, 3, v7
  v_add_u32 v73, 65536, v7
  v_lshlrev_b32 v7, 6, v8
  v_and_b32 v11, 1, v3
  v_lshl_add_u32 v7, v11, 5, v7
  v_lshl_add_u32 v7, v10, 3, v7
  s_lshl_b32 s41, s3, 12
  v_add_u32 v78, s41, v7
  v_xor_b32 v79, 32, v78
  v_lshlrev_b32 v7, 7, v8
  v_lshrrev_b32 v9, 1, v9
  v_lshl_or_b32 v9, v11, 1, v9
  v_lshl_add_u32 v7, v9, 5, v7
  v_lshl_add_u32 v7, v10, 3, v7
  s_add_u32 s41, s41, 98304
  v_add_u32 v94, s41, v7
  s_lshl_b32 s41, s43, 14
  s_lshr_b32 s42, s3, 1
  s_lshl_b32 s42, s42, 10
  s_add_u32 s41, s41, s42
  s_and_b32 s42, s3, 1
  s_lshl_b32 s42, s42, 9
  s_add_u32 s41, s41, s42
  s_lshl_b32 s42, s35, 4
  s_add_u32 s41, s41, s42
  s_add_u32 s41, s41, 262144
  v_lshlrev_b32 v74, 12, v3
  v_lshrrev_b32 v7, 3, v2
  v_lshl_add_u32 v74, v7, 8, v74
  v_and_b32 v7, 7, v2
  v_lshl_add_u32 v74, v7, 1, v74
  v_add_u32 v74, s41, v74
  s_lshl_b32 s41, s43, 8
  s_lshl_b32 s42, s35, 2
  s_add_u32 s41, s41, s42
  s_add_u32 s41, s41, 524288
  v_lshl_add_u32 v75, v3, 6, s41
  s_lshr_b32 s45, s35, 3
  s_lshl_b32 s41, s43, 14
  s_lshl_b32 s42, s45, 13
  s_add_u32 s41, s41, s42
  s_lshl_b32 s42, s3, 10
  s_add_u32 s41, s41, s42
  s_add_u32 s41, s41, 262144
  v_lshl_add_u32 v76, v0, 4, s41
  s_lshl_b32 s41, s43, 8
  s_lshl_b32 s42, s45, 7
  s_add_u32 s41, s41, s42
  s_lshr_b32 s42, s3, 2
  s_lshl_b32 s42, s42, 6
  s_add_u32 s41, s41, s42
  s_add_u32 s41, s41, 524288
  v_lshl_add_u32 v77, v3, 4, s41
  v_subrev_u32 v132, 98304, v94
  s_lshl_b32 s41, s3, 9
  s_add_u32 s41, s41, 152064
  v_lshl_add_u32 v95, v0, 2, s41
  v_lshlrev_b32 v96, 2, v0
  v_add_u32 v96, 152064, v96
  s_lshl_b32 s41, s36, 9
  s_lshl_b32 s42, s3, 7
  s_add_u32 s41, s41, s42
  s_add_u32 s41, s41, 589824
  v_lshrrev_b32 v7, 5, v0
  v_lshlrev_b32 v7, 8, v7
  v_and_b32 v8, 31, v0
  v_lshl_add_u32 v7, v8, 2, v7
  v_add_u32 v97, s41, v7
  v_lshrrev_b32 v7, 1, v3
  v_lshlrev_b32 v7, 14, v7
  v_and_b32 v8, 1, v3
  v_lshl_add_u32 v7, v8, 12, v7
  v_lshl_add_u32 v7, v2, 4, v7
  s_lshl_b32 s41, s34, 4
  s_add_u32 s41, s41, s39
  s_lshl_b32 s41, s41, 9
  s_lshl_b32 s42, s37, 8
  s_add_u32 s41, s41, s42
  s_add_u32 s41, s41, 589824
  v_add_u32 v100, s41, v7
  v_add_u32 v101, 32768, v100
  v_add_u32 v102, 65536, v100
  v_add_u32 v103, 98304, v100
  v_lshlrev_b32 v108, 4, v3
  v_add_u32 v109, 4, v108
  v_add_u32 v110, 8, v108
  v_add_u32 v111, 12, v108
L_QW:
  ds_read_b64 v[88:89], v91 offset:8
  s_waitcnt lgkmcnt(0)
  v_readfirstlane_b32 s41, v88
  v_readfirstlane_b32 s45, v89
  s_cmp_eq_u32 s50, 0
  s_cbranch_scc0 L_QW1
  s_cmp_eq_u32 s41, 1
  s_cbranch_scc0 L_QW1
  global_store_dword v98, v99, s[52:53] sc1
  s_mov_b32 s50, 1
  s_cmp_eq_u32 s3, 0
  s_cbranch_scc0 L_QW1
  s_mov_b64 exec, 1
  global_store_dword v114, v112, s[26:27] sc1
  s_mov_b64 exec, -1
L_QW1:
  s_cmp_ge_u32 s45, 2
  s_cbranch_scc1 L_QWD
  s_cmp_eq_u32 s44, 0
  s_cbranch_scc1 L_QWD
  s_sub_u32 s44, s44, 1
  s_sleep 1
  s_branch L_QW
L_QWD:
  ds_read_b128 v[10:13], v6
  ds_read_b128 v[14:17], v6 offset:64
  ds_read_b128 v[18:21], v6 offset:128
  ds_read_b128 v[22:25], v6 offset:192
W_7:
  ds_read_b32 v90, v91 offset:0
  s_waitcnt lgkmcnt(0)
  v_readfirstlane_b32 s45, v90
  s_cmp_ge_u32 s45, 20
  s_cbranch_scc1 WD_8
  s_cmp_eq_u32 s44, 0
  s_cbranch_scc1 WD_8
  s_sub_u32 s44, s44, 1
  s_sleep 1
  s_branch W_7
WD_8:
  ds_read_b128 v[30:33], v26 offset:0
  ds_read_b128 v[34:37], v27 offset:0
  ds_read_b128 v[38:41], v28 offset:0
  ds_read_b128 v[42:45], v29 offset:0
  ds_read_b128 v[46:49], v26 offset:4096
  ds_read_b128 v[50:53], v27 offset:4096
  ds_read_b128 v[54:57], v28 offset:4096
  ds_read_b128 v[58:61], v29 offset:4096
  s_waitcnt lgkmcnt(4)
  v_mfma_f32_16x16x32_bf16 v[62:65], v[10:13], v[30:33], 0
  v_mfma_f32_16x16x32_bf16 v[62:65], v[14:17], v[34:37], v[62:65]
  v_mfma_f32_16x16x32_bf16 v[62:65], v[18:21], v[38:41], v[62:65]
  v_mfma_f32_16x16x32_bf16 v[62:65], v[22:25], v[42:45], v[62:65]
  s_waitcnt lgkmcnt(0)
  v_mfma_f32_16x16x32_bf16 v[66:69], v[10:13], v[46:49], 0
  v_mfma_f32_16x16x32_bf16 v[66:69], v[14:17], v[50:53], v[66:69]
  v_mfma_f32_16x16x32_bf16 v[66:69], v[18:21], v[54:57], v[66:69]
  v_mfma_f32_16x16x32_bf16 v[66:69], v[22:25], v[58:61], v[66:69]
  v_lshlrev_b32 v6, 5, v3
  s_lshl_b32 s41, s3, 2
  s_add_u32 s41, s41, 158208
  v_add_u32 v7, s41, v6
  v_add_u32 v9, 128, v7
  v_mul_u32_u24 v8, 576, v3
  v_lshl_add_u32 v8, v2, 1, v8
  s_lshl_b32 s41, s3, 6
  s_add_u32 s41, s41, 155648
  v_add_u32 v8, s41, v8
  v_cvt_pk_bf16_f32 v62, v62, v62
  v_lshlrev_b32 v62, 16, v62
  v_cvt_pk_bf16_f32 v66, v66, v66
  v_lshlrev_b32 v66, 16, v66
  v_mul_f32 v62, 0x3db504f3, v62
  v_mul_f32 v66, 0x3db504f3, v66
  v_cvt_pk_bf16_f32 v62, v62, v62
  v_lshlrev_b32 v62, 16, v62
  v_cvt_pk_bf16_f32 v66, v66, v66
  v_lshlrev_b32 v66, 16, v66
  v_mul_f32 v62, 0x3fb8aa3b, v62
  v_mul_f32 v66, 0x3fb8aa3b, v66
  v_max_f32 v63, v62, v66
  s_nop 1
  v_max_f32_dpp v63, v63, v63 row_ror:8 row_mask:0xf bank_mask:0xf
  s_nop 1
  v_max_f32_dpp v63, v63, v63 row_ror:4 row_mask:0xf bank_mask:0xf
  s_nop 1
  v_max_f32_dpp v63, v63, v63 row_ror:2 row_mask:0xf bank_mask:0xf
  s_nop 1
  v_max_f32_dpp v63, v63, v63 row_ror:1 row_mask:0xf bank_mask:0xf
  ds_write_b32 v7, v63
  v_sub_f32 v62, v62, v63
  v_sub_f32 v66, v66, v63
  v_exp_f32 v62, v62
  v_exp_f32 v66, v66
  s_nop 0
  v_cvt_pk_bf16_f32 v62, v62, v62
  v_cvt_pk_bf16_f32 v66, v66, v66
  ds_write_b16 v8, v62
  ds_write_b16 v8, v66 offset:32
  v_lshlrev_b32 v62, 16, v62
  v_lshlrev_b32 v66, 16, v66
  v_add_f32 v63, v62, v66
  s_nop 1
  v_add_f32_dpp v63, v63, v63 row_ror:8 row_mask:0xf bank_mask:0xf
  s_nop 1
  v_add_f32_dpp v63, v63, v63 row_ror:4 row_mask:0xf bank_mask:0xf
  s_nop 1
  v_add_f32_dpp v63, v63, v63 row_ror:2 row_mask:0xf bank_mask:0xf
  s_nop 1
  v_add_f32_dpp v63, v63, v63 row_ror:1 row_mask:0xf bank_mask:0xf
  ds_write_b32 v9, v63
  s_mov_b64 exec, 1
  ds_add_u32 v91, v92 offset:16
  s_mov_b64 exec, -1
W_9:
  ds_read_b32 v90, v91 offset:16
  s_waitcnt lgkmcnt(0)
  v_readfirstlane_b32 s45, v90
  s_cmp_ge_u32 s45, 8
  s_cbranch_scc1 WD_10
  s_cmp_eq_u32 s44, 0
  s_cbranch_scc1 WD_10
  s_sub_u32 s44, s44, 1
  s_branch W_9
WD_10:
  v_add_u32 v7, 158336, v6
  v_add_u32 v9, 158208, v6
  ds_read_b128 v[10:13], v7
  ds_read_b128 v[14:17], v7 offset:16
  ds_read_b128 v[18:21], v9
  ds_read_b128 v[22:25], v9 offset:16
  v_lshrrev_b32 v8, 2, v2
  v_mul_u32_u24 v8, 576, v8
  v_lshl_add_u32 v8, v3, 4, v8
  v_add_u32 v8, 155648, v8
  ds_read_b128 v[30:33], v8 offset:0
  ds_read_b128 v[34:37], v8 offset:64
  ds_read_b128 v[38:41], v8 offset:128
  ds_read_b128 v[42:45], v8 offset:192
  ds_read_b128 v[46:49], v8 offset:256
  ds_read_b128 v[50:53], v8 offset:320
  ds_read_b128 v[54:57], v8 offset:384
  ds_read_b128 v[58:61], v8 offset:448
  s_waitcnt lgkmcnt(8)
  v_max3_f32 v70, v18, v19, v20
  v_max3_f32 v71, v21, v22, v23
  v_max3_f32 v70, v70, v24, v25
  v_max_f32 v70, v70, v71
  v_sub_f32 v18, v18, v70
  v_exp_f32 v18, v18
  v_sub_f32 v19, v19, v70
  v_exp_f32 v19, v19
  v_sub_f32 v20, v20, v70
  v_exp_f32 v20, v20
  v_sub_f32 v21, v21, v70
  v_exp_f32 v21, v21
  v_sub_f32 v22, v22, v70
  v_exp_f32 v22, v22
  v_sub_f32 v23, v23, v70
  v_exp_f32 v23, v23
  v_sub_f32 v24, v24, v70
  v_exp_f32 v24, v24
  v_sub_f32 v25, v25, v70
  v_exp_f32 v25, v25
  s_nop 0
  v_mul_f32 v71, v10, v18
  v_fmac_f32 v71, v11, v19
  v_fmac_f32 v71, v12, v20
  v_fmac_f32 v71, v13, v21
  v_fmac_f32 v71, v14, v22
  v_fmac_f32 v71, v15, v23
  v_fmac_f32 v71, v16, v24
  v_fmac_f32 v71, v17, v25
  v_log_f32 v72, v71
  v_rcp_f32 v71, v71
  s_nop 0
  v_add_f32 v72, v72, v70
  v_mul_f32 v82, v18, v71
  v_mul_f32 v83, v19, v71
  v_mul_f32 v84, v20, v71
  v_mul_f32 v85, v21, v71
  v_mul_f32 v86, v22, v71
  v_mul_f32 v87, v23, v71
  v_mul_f32 v88, v24, v71
  v_mul_f32 v89, v25, v71
  s_mov_b32 s46, 0x55555555
  s_mov_b32 s47, 0x55555555
  s_waitcnt lgkmcnt(0)
W_11:
  ds_read_b32 v90, v91 offset:8
  s_waitcnt lgkmcnt(0)
  v_readfirstlane_b32 s51, v90
  s_cmp_ge_u32 s51, 1
  s_cbranch_scc1 WD_12
  s_cmp_eq_u32 s44, 0
  s_cbranch_scc1 WD_12
  s_sub_u32 s44, s44, 1
  s_sleep 1
  s_branch W_11
WD_12:
  s_cmp_eq_u32 s50, 0
  s_cbranch_scc0 L_QBD
  s_cmp_eq_u32 s51, 1
  s_cbranch_scc0 L_QBD
  global_store_dword v98, v99, s[52:53] sc1
  s_cmp_eq_u32 s3, 0
  s_cbranch_scc0 L_QBD
  s_mov_b64 exec, 1
  global_store_dword v114, v112, s[26:27] sc1
  s_mov_b64 exec, -1
L_QBD:
  s_lshr_b32 s41, s35, 1
  s_mul_i32 s42, s28, 7
  s_add_u32 s41, s41, s42
  s_mul_i32 s42, s3, 229376
  s_lshl_b32 s45, s41, 6
  s_add_u32 s42, s42, s45
  s_add_u32 s52, s16, s42
  s_addc_u32 s53, s17, 0
  s_add_u32 s54, s18, s42
  s_addc_u32 s55, s19, 0
  s_lshl_b32 s42, s41, 15
  s_lshl_b32 s45, s3, 7
  s_add_u32 s42, s42, s45
  s_add_u32 s56, s20, s42
  s_addc_u32 s57, s21, 0
  s_lshl_b32 s42, s3, 12
  s_add_u32 s58, s42, 32768
  s_add_u32 s59, s42, 65536
  s_add_u32 s60, s42, 98304
  v_lshrrev_b32 v136, 2, v0
  v_mul_u32_u24 v136, 3584, v136
  v_lshrrev_b32 v7, 5, v0
  v_lshlrev_b32 v7, 1, v7
  v_and_b32 v8, 3, v0
  v_xor_b32 v7, v7, v8
  v_lshl_add_u32 v136, v7, 4, v136
  v_lshrrev_b32 v6, 3, v0
  v_and_b32 v7, 7, v0
  v_lshrrev_b32 v8, 1, v6
  v_and_b32 v8, 1, v8
  v_lshlrev_b32 v8, 1, v8
  v_xor_b32 v7, v7, v8
  v_lshlrev_b32 v7, 4, v7
  v_lshl_add_u32 v137, v6, 10, v7
  v_xor_b32 v138, 64, v137
  s_lshl_b32 s41, s3, 7
  s_add_u32 s41, s41, 158720
  v_lshl_add_u32 v6, v2, 2, v3
  v_lshl_add_u32 v139, v6, 1, s41
  v_lshl_add_u32 v140, v3, 4, s41
  v_and_b32 v6, 1, v0
  v_cmp_eq_u32 vcc, 1, v6
  v_mov_b32 v7, 160384
  v_lshl_add_u32 v7, v3, 4, v7
  v_and_b32 v142, 31, v0
  v_cndmask_b32 v140, v140, v7, vcc
  s_lshl_b32 s41, s3, 6
  s_add_u32 s41, s41, 159744
  v_lshl_add_u32 v142, v142, 1, s41
  v_lshl_add_u32 v143, v3, 4, s41
  s_lshl_b32 s41, s36, 10
  s_lshl_b32 s42, s3, 7
  s_add_u32 s41, s41, s42
  s_add_u32 s41, s41, 786432
  v_lshl_add_u32 v144, v0, 1, s41
  s_lshl_b32 s41, s3, 9
  s_add_u32 s41, s41, 152064
  v_lshl_add_u32 v145, v0, 3, s41
  v_lshlrev_b32 v146, 3, v0
  v_add_u32 v146, 152064, v146
  s_lshl_b32 s41, s3, 3
  s_add_u32 s41, s41, 160256
  v_mov_b32 v147, s41
  v_mov_b32 v141, 160256
  v_add_u32 v153, 32768, v78
  v_add_u32 v154, 32768, v79
  v_xor_b32 v148, 32, v94
  v_xor_b32 v149, 64, v94
  v_xor_b32 v150, 96, v94
  v_add_u32 v151, 65536, v78
  v_add_u32 v152, 65536, v79
  s_mul_i32 s41, s28, 7
  s_lshr_b32 s41, s41, 1
  s_lshl_b32 s41, s41, 7
  s_mul_i32 s42, s29, 57344
  s_add_u32 s41, s41, s42
  v_lshrrev_b32 v6, 2, v0
  v_mul_u32_u24 v6, 3584, v6
  v_and_b32 v7, 3, v0
  v_lshl_add_u32 v6, v7, 7, v6
  v_add_u32 v155, s41, v6
  s_mul_i32 s41, s28, 229376
  s_mul_i32 s42, s29, 7168
  s_add_u32 s41, s41, s42
  v_min_u32 v7, 55, v0
  v_lshl_add_u32 v156, v7, 7, s41
  s_waitcnt vmcnt(0)
  v_lshlrev_b32 v93, 16, v93
W_13:
  ds_read_b32 v90, v91 offset:0
  s_waitcnt lgkmcnt(0)
  v_readfirstlane_b32 s45, v90
  s_cmp_ge_u32 s45, 24
  s_cbranch_scc1 WD_14
  s_cmp_eq_u32 s44, 0
  s_cbranch_scc1 WD_14
  s_sub_u32 s44, s44, 1
  s_sleep 1
  s_branch W_13
WD_14:
  ds_read_b64_tr_b16 v[10:11], v73 offset:0
  ds_read_b64_tr_b16 v[12:13], v73 offset:1024
  ds_read_b64_tr_b16 v[14:15], v73 offset:8192
  ds_read_b64_tr_b16 v[16:17], v73 offset:9216
  s_waitcnt lgkmcnt(2)
  v_mfma_f32_16x16x32_bf16 v[62:65], v[30:33], v[10:13], 0
  s_waitcnt lgkmcnt(0)
  v_mfma_f32_16x16x32_bf16 v[66:69], v[34:37], v[14:17], 0
W_15:
  ds_read_b32 v90, v91 offset:0
  s_waitcnt lgkmcnt(0)
  v_readfirstlane_b32 s45, v90
  s_cmp_ge_u32 s45, 28
  s_cbranch_scc1 WD_16
  s_cmp_eq_u32 s44, 0
  s_cbranch_scc1 WD_16
  s_sub_u32 s44, s44, 1
  s_sleep 1
  s_branch W_15
WD_16:
  ds_read_b64_tr_b16 v[10:11], v73 offset:16384
  ds_read_b64_tr_b16 v[12:13], v73 offset:17408
  ds_read_b64_tr_b16 v[14:15], v73 offset:24576
  ds_read_b64_tr_b16 v[16:17], v73 offset:25600
  v_mul_f32 v70, v62, v82
  v_fmac_f32 v70, v66, v83
  s_waitcnt lgkmcnt(2)
  v_mfma_f32_16x16x32_bf16 v[62:65], v[38:41], v[10:13], 0
  s_waitcnt lgkmcnt(0)
  v_mfma_f32_16x16x32_bf16 v[66:69], v[42:45], v[14:17], 0
W_17:
  ds_read_b32 v90, v91 offset:0
  s_waitcnt lgkmcnt(0)
  v_readfirstlane_b32 s45, v90
  s_cmp_ge_u32 s45, 32
  s_cbranch_scc1 WD_18
  s_cmp_eq_u32 s44, 0
  s_cbranch_scc1 WD_18
  s_sub_u32 s44, s44, 1
  s_branch W_17
WD_18:
  ds_read_b64_tr_b16 v[10:11], v73 offset:32768
  ds_read_b64_tr_b16 v[12:13], v73 offset:33792
  ds_read_b64_tr_b16 v[14:15], v73 offset:40960
  ds_read_b64_tr_b16 v[16:17], v73 offset:41984
  v_fmac_f32 v70, v62, v84
  v_fmac_f32 v70, v66, v85
  s_waitcnt lgkmcnt(2)
  v_mfma_f32_16x16x32_bf16 v[62:65], v[46:49], v[10:13], 0
  s_waitcnt lgkmcnt(0)
  v_mfma_f32_16x16x32_bf16 v[66:69], v[50:53], v[14:17], 0
W_19:
  ds_read_b32 v90, v91 offset:0
  s_waitcnt lgkmcnt(0)
  v_readfirstlane_b32 s45, v90
  s_cmp_ge_u32 s45, 36
  s_cbranch_scc1 WD_20
  s_cmp_eq_u32 s44, 0
  s_cbranch_scc1 WD_20
  s_sub_u32 s44, s44, 1
  s_branch W_19
WD_20:
  ds_read_b64_tr_b16 v[10:11], v73 offset:49152
  ds_read_b64_tr_b16 v[12:13], v73 offset:50176
  ds_read_b64_tr_b16 v[14:15], v73 offset:57344
  ds_read_b64_tr_b16 v[16:17], v73 offset:58368
  v_fmac_f32 v70, v62, v86
  v_fmac_f32 v70, v66, v87
  s_waitcnt lgkmcnt(2)
  v_mfma_f32_16x16x32_bf16 v[62:65], v[54:57], v[10:13], 0
  s_waitcnt lgkmcnt(0)
  v_mfma_f32_16x16x32_bf16 v[66:69], v[58:61], v[14:17], 0
  s_nop 6
  v_fmac_f32 v70, v62, v88
  v_fmac_f32 v70, v66, v89
  s_nop 1
  v_mov_b32_dpp v63, v70 quad_perm:[1,0,3,2] row_mask:0xf bank_mask:0xf
  s_nop 0
  v_cvt_pk_bf16_f32 v62, v70, v63
  s_cmp_eq_u32 s51, 2
  s_cbranch_scc0 PS_21
  s_mov_b64 exec, s[46:47]
  global_store_dword v74, v62, s[26:27]
  s_mov_b64 exec, -1
  s_cmp_lg_u32 s3, 0
  s_cbranch_scc1 PE_22
  global_store_dword v75, v72, s[26:27]
  s_branch PE_22
PS_21:
  s_mov_b64 exec, s[46:47]
  global_store_dword v74, v62, s[26:27] sc1
  s_mov_b64 exec, -1
  s_cmp_lg_u32 s3, 0
  s_cbranch_scc1 PE_22
  global_store_dword v75, v72, s[26:27] sc1
PE_22:
  s_mov_b64 exec, 1
  ds_add_u32 v91, v92 offset:28
  s_mov_b64 exec, -1
W_23:
  ds_read_b32 v90, v91 offset:28
  s_waitcnt lgkmcnt(0)
  v_readfirstlane_b32 s45, v90
  s_cmp_ge_u32 s45, 8
  s_cbranch_scc1 WD_24
  s_cmp_eq_u32 s44, 0
  s_cbranch_scc1 WD_24
  s_sub_u32 s44, s44, 1
  s_branch W_23
WD_24:
  global_load_dwordx4 v[10:13], v76, s[26:27] sc1
  global_load_dwordx4 v[14:17], v77, s[26:27] sc1
  s_mov_b64 exec, 1
  ds_add_u32 v91, v92 offset:24
  s_mov_b64 exec, -1
W_25:
  ds_read_b32 v90, v91 offset:0
  s_waitcnt lgkmcnt(0)
  v_readfirstlane_b32 s45, v90
  s_cmp_ge_u32 s45, 44
  s_cbranch_scc1 WD_26
  s_cmp_eq_u32 s44, 0
  s_cbranch_scc1 WD_26
  s_sub_u32 s44, s44, 1
  s_branch W_25
WD_26:
  v_xor_b32 v133, 32, v132
  v_xor_b32 v134, 64, v132
  v_xor_b32 v135, 96, v132
  ds_read_b64_tr_b16 v[112:113], v132
  ds_read_b64_tr_b16 v[114:115], v132 offset:512
  ds_read_b64_tr_b16 v[116:117], v133
  ds_read_b64_tr_b16 v[118:119], v133 offset:512
  ds_read_b64_tr_b16 v[120:121], v134
  ds_read_b64_tr_b16 v[122:123], v134 offset:512
  ds_read_b64_tr_b16 v[124:125], v135
  ds_read_b64_tr_b16 v[126:127], v135 offset:512
  s_waitcnt vmcnt(0)
  v_max3_u32 v18, v10, v11, v12
  v_max3_u32 v19, v13, v14, v15
  v_max3_u32 v18, v18, v16, v17
  v_max_u32 v18, v18, v19
  v_cmp_eq_u32 vcc, -1, v18
  s_cbranch_vccz L_H1GOTX
  s_cmp_eq_u32 s44, 0
  s_cbranch_scc1 L_H1GOTX
  s_sub_u32 s44, s44, 1
L_H1POLL:
  global_load_dwordx4 v[10:13], v76, s[26:27] sc1
  global_load_dwordx4 v[14:17], v77, s[26:27] sc1
  s_waitcnt vmcnt(0)
  v_max3_u32 v18, v10, v11, v12
  v_max3_u32 v19, v13, v14, v15
  v_max3_u32 v18, v18, v16, v17
  v_max_u32 v18, v18, v19
  v_cmp_eq_u32 vcc, -1, v18
  s_cbranch_vccz L_H1GOTX
  s_cmp_eq_u32 s44, 0
  s_cbranch_scc1 L_H1GOTX
  s_sub_u32 s44, s44, 1
  s_branch L_H1POLL
L_H1GOTX:
  s_waitcnt lgkmcnt(0)
  v_mfma_f32_16x16x32_bf16 v[20:23], v[10:13], v[112:115], 0
  v_mfma_f32_16x16x32_bf16 v[24:27], v[10:13], v[116:119], 0
  v_mfma_f32_16x16x32_bf16 v[28:31], v[10:13], v[120:123], 0
  v_mfma_f32_16x16x32_bf16 v[32:35], v[10:13], v[124:127], 0
  v_max3_f32 v18, v14, v15, v16
  v_max_f32 v18, v18, v17
  v_mov_b32 v19, v18
  s_nop 1
  v_permlane16_swap_b32 v18, v19
  s_nop 1
  v_max_f32 v18, v18, v19
  v_sub_f32 v14, v14, v18
  v_sub_f32 v15, v15, v18
  v_sub_f32 v16, v16, v18
  v_sub_f32 v17, v17, v18
  v_exp_f32 v14, v14
  v_exp_f32 v15, v15
  v_exp_f32 v16, v16
  v_exp_f32 v17, v17
  s_nop 0
  v_add_f32 v18, v14, v15
  v_add_f32 v19, v16, v17
  v_add_f32 v18, v18, v19
  v_mul_f32 v20, v20, v14
  v_mul_f32 v24, v24, v14
  v_mul_f32 v28, v28, v14
  v_mul_f32 v32, v32, v14
  v_mov_b32 v19, v18
  v_fmac_f32 v20, v21, v15
  v_fmac_f32 v24, v25, v15
  v_fmac_f32 v28, v29, v15
  v_fmac_f32 v32, v33, v15
  v_permlane16_swap_b32 v18, v19
  v_fmac_f32 v20, v22, v16
  v_fmac_f32 v24, v26, v16
  v_fmac_f32 v28, v30, v16
  v_fmac_f32 v32, v34, v16
  v_add_f32 v18, v18, v19
  v_rcp_f32 v18, v18
  v_fmac_f32 v20, v23, v17
  v_fmac_f32 v24, v27, v17
  v_fmac_f32 v28, v31, v17
  v_fmac_f32 v32, v35, v17
L_H1DONE:
  s_nop 0
  v_permlane16_swap_b32 v20, v24
  v_permlane16_swap_b32 v28, v32
  s_nop 1
  v_add_f32 v20, v20, v24
  v_add_f32 v28, v28, v32
  v_mul_f32 v20, v20, v18
  v_mul_f32 v28, v28, v18
  ds_write_b32 v95, v20
  ds_write_b32 v95, v28 offset:256
  s_waitcnt lgkmcnt(0)
  s_barrier
  s_cmp_ge_u32 s3, 2
  s_cbranch_scc1 L_H2PUBD
  s_lshl_b32 s41, s3, 8
  v_add_u32 v6, s41, v96
  ds_read_b32 v52, v6 offset:0
  ds_read_b32 v53, v6 offset:512
  ds_read_b32 v54, v6 offset:1024
  ds_read_b32 v55, v6 offset:1536
  ds_read_b32 v56, v6 offset:2048
  ds_read_b32 v57, v6 offset:2560
  ds_read_b32 v58, v6 offset:3072
  ds_read_b32 v59, v6 offset:3584
  s_mov_b32 s46, 0xffffff00
  s_waitcnt lgkmcnt(0)
  v_add_f32 v52, v52, v53
  v_add_f32 v54, v54, v55
  v_add_f32 v56, v56, v57
  v_add_f32 v58, v58, v59
  v_add_f32 v52, v52, v54
  v_add_f32 v56, v56, v58
  v_add_f32 v52, v52, v56
  v_add_u32 v52, 0x80, v52
  v_bfi_b32 v52, s46, v52, v80
  global_store_dword v97, v52, s[26:27] sc1
L_H2PUBD:
  s_barrier
  s_cmp_ge_u32 s35, 14
  s_cbranch_scc1 L_NOFFNW
  s_mov_b32 m0, s58
  s_add_u32 s58, s58, 1024
  global_load_lds_dwordx4 v136, s[52:53]
  s_add_u32 s52, s52, 57344
  s_addc_u32 s53, s53, 0
  s_mov_b32 m0, s58
  s_add_u32 s58, s58, 1024
  global_load_lds_dwordx4 v136, s[52:53]
  s_add_u32 s52, s52, 57344
  s_addc_u32 s53, s53, 0
  s_mov_b32 m0, s58
  s_add_u32 s58, s58, 1024
  global_load_lds_dwordx4 v136, s[52:53]
  s_add_u32 s52, s52, 57344
  s_addc_u32 s53, s53, 0
  s_mov_b32 m0, s58
  s_add_u32 s58, s58, 1024
  global_load_lds_dwordx4 v136, s[52:53]
  s_add_u32 s52, s52, 57344
  s_addc_u32 s53, s53, 0
  s_mov_b32 m0, s59
  s_add_u32 s59, s59, 1024
  global_load_lds_dwordx4 v136, s[54:55]
  s_add_u32 s54, s54, 57344
  s_addc_u32 s55, s55, 0
  s_mov_b32 m0, s59
  s_add_u32 s59, s59, 1024
  global_load_lds_dwordx4 v136, s[54:55]
  s_add_u32 s54, s54, 57344
  s_addc_u32 s55, s55, 0
  s_barrier
L_NOFFNW:
  s_and_b32 s46, s31, 0xff
  s_lshr_b32 s47, s31, 8
  s_add_u32 s47, s47, s31
  s_add_u32 s47, s47, 64
  s_and_b32 s47, s47, 0xff
  s_lshr_b32 s48, s31, 16
  s_add_u32 s48, s48, s31
  s_add_u32 s48, s48, 128
  s_and_b32 s48, s48, 0xff
  s_lshr_b32 s49, s31, 24
  s_add_u32 s49, s49, s31
  s_add_u32 s49, s49, 192
  s_and_b32 s49, s49, 0xff
  s_cmp_ge_u32 s35, 14
  s_cselect_b32 s61, 1, 0
  s_movk_i32 s63, 0xff
  global_load_dwordx4 v[104:107], v100, s[26:27] sc1
  global_load_dwordx4 v[108:111], v101, s[26:27] sc1
  global_load_dwordx4 v[112:115], v102, s[26:27] sc1
  global_load_dwordx4 v[116:119], v103, s[26:27] sc1
  s_cmp_eq_u32 s61, 0
  s_cbranch_scc0 L_H2W0
  s_mov_b32 m0, s59
  s_add_u32 s59, s59, 1024
  global_load_lds_dwordx4 v136, s[54:55]
  s_add_u32 s54, s54, 57344
  s_addc_u32 s55, s55, 0
  s_mov_b32 m0, s59
  s_add_u32 s59, s59, 1024
  global_load_lds_dwordx4 v136, s[54:55]
  s_add_u32 s54, s54, 57344
  s_addc_u32 s55, s55, 0
  s_mov_b32 m0, s60
  s_add_u32 s60, s60, 1024
  global_load_lds_dwordx4 v137, s[56:57]
  s_add_u32 s56, s56, 8192
  s_addc_u32 s57, s57, 0
  s_mov_b32 m0, s60
  s_add_u32 s60, s60, 1024
  global_load_lds_dwordx4 v138, s[56:57]
  s_add_u32 s56, s56, 8192
  s_addc_u32 s57, s57, 0
  s_mov_b32 m0, s60
  s_add_u32 s60, s60, 1024
  global_load_lds_dwordx4 v137, s[56:57]
  s_add_u32 s56, s56, 8192
  s_addc_u32 s57, s57, 0
  s_mov_b32 m0, s60
  s_add_u32 s60, s60, 1024
  global_load_lds_dwordx4 v138, s[56:57]
  s_add_u32 s56, s56, 8192
  s_addc_u32 s57, s57, 0
  s_waitcnt vmcnt(6)
  s_branch L_NOFR
L_H2W0:
  s_waitcnt vmcnt(0)
L_NOFR:
  v_xor_b32 v14, s46, v104
  v_xor_b32 v15, s47, v105
  v_xor_b32 v16, s48, v106
  v_xor_b32 v17, s49, v107
  v_bitop3_b32 v14, v108, s46, v14 bitop3:0xbe
  v_bitop3_b32 v15, v109, s47, v15 bitop3:0xbe
  v_bitop3_b32 v16, v110, s48, v16 bitop3:0xbe
  v_bitop3_b32 v17, v111, s49, v17 bitop3:0xbe
  v_bitop3_b32 v14, v112, s46, v14 bitop3:0xbe
  v_bitop3_b32 v15, v113, s47, v15 bitop3:0xbe
  v_bitop3_b32 v16, v114, s48, v16 bitop3:0xbe
  v_bitop3_b32 v17, v115, s49, v17 bitop3:0xbe
  v_bitop3_b32 v14, v116, s46, v14 bitop3:0xbe
  v_bitop3_b32 v15, v117, s47, v15 bitop3:0xbe
  v_bitop3_b32 v16, v118, s48, v16 bitop3:0xbe
  v_bitop3_b32 v17, v119, s49, v17 bitop3:0xbe
  v_or3_b32 v14, v14, v15, v16
  v_and_b32 v17, 0xff, v17
  v_and_or_b32 v14, v14, s63, v17
  v_cmp_ne_u32 vcc, 0, v14
  s_cbranch_vccz L_H2GOTA
  s_cmp_eq_u32 s44, 0
  s_cbranch_scc1 L_H2GOTA
  s_sub_u32 s44, s44, 1
L_H2POLL:
  global_load_dwordx4 v[104:107], v100, s[26:27] sc1
  global_load_dwordx4 v[108:111], v101, s[26:27] sc1
  global_load_dwordx4 v[112:115], v102, s[26:27] sc1
  global_load_dwordx4 v[116:119], v103, s[26:27] sc1
  s_waitcnt vmcnt(0)
  v_xor_b32 v14, s46, v104
  v_xor_b32 v15, s47, v105
  v_xor_b32 v16, s48, v106
  v_xor_b32 v17, s49, v107
  v_bitop3_b32 v14, v108, s46, v14 bitop3:0xbe
  v_bitop3_b32 v15, v109, s47, v15 bitop3:0xbe
  v_bitop3_b32 v16, v110, s48, v16 bitop3:0xbe
  v_bitop3_b32 v17, v111, s49, v17 bitop3:0xbe
  v_bitop3_b32 v14, v112, s46, v14 bitop3:0xbe
  v_bitop3_b32 v15, v113, s47, v15 bitop3:0xbe
  v_bitop3_b32 v16, v114, s48, v16 bitop3:0xbe
  v_bitop3_b32 v17, v115, s49, v17 bitop3:0xbe
  v_bitop3_b32 v14, v116, s46, v14 bitop3:0xbe
  v_bitop3_b32 v15, v117, s47, v15 bitop3:0xbe
  v_bitop3_b32 v16, v118, s48, v16 bitop3:0xbe
  v_bitop3_b32 v17, v119, s49, v17 bitop3:0xbe
  v_or3_b32 v14, v14, v15, v16
  v_and_b32 v17, 0xff, v17
  v_and_or_b32 v14, v14, s63, v17
  v_cmp_ne_u32 vcc, 0, v14
  s_cbranch_vccz L_H2GOTA
  s_cmp_eq_u32 s44, 0
  s_cbranch_scc1 L_H2GOTA
  s_sub_u32 s44, s44, 1
  s_branch L_H2POLL
L_H2GOTA:
  s_cmp_eq_u32 s61, 0
  s_cbranch_scc0 L_NOFR2
  s_waitcnt vmcnt(4)
  ds_read_b64_tr_b16 v[46:47], v153 offset:0
  ds_read_b64_tr_b16 v[48:49], v153 offset:256
  ds_read_b64_tr_b16 v[50:51], v154 offset:0
  ds_read_b64_tr_b16 v[52:53], v154 offset:256
  ds_read_b64_tr_b16 v[54:55], v151 offset:0
  ds_read_b64_tr_b16 v[56:57], v151 offset:256
  ds_read_b64_tr_b16 v[58:59], v152 offset:0
  ds_read_b64_tr_b16 v[60:61], v152 offset:256
  ds_read_b64_tr_b16 v[62:63], v153 offset:2048
  ds_read_b64_tr_b16 v[64:65], v153 offset:2304
  ds_read_b64_tr_b16 v[66:67], v154 offset:2048
  ds_read_b64_tr_b16 v[68:69], v154 offset:2304
L_NOFR2:
  v_add_f32 v104, v104, v108
  v_add_f32 v112, v112, v116
  v_add_f32 v105, v105, v109
  v_add_f32 v113, v113, v117
  v_add_f32 v106, v106, v110
  v_add_f32 v114, v114, v118
  v_add_f32 v107, v107, v111
  v_add_f32 v115, v115, v119
  v_add_f32 v104, v104, v112
  v_add_f32 v105, v105, v113
  v_add_f32 v106, v106, v114
  v_add_f32 v107, v107, v115
  s_nop 0
  v_permlane16_swap_b32 v104, v105
  v_permlane16_swap_b32 v106, v107
  s_nop 1
  v_add_f32 v104, v104, v105
  v_add_f32 v106, v106, v107
  s_nop 1
  v_permlane32_swap_b32 v104, v106
  s_nop 1
  v_add_f32 v30, v104, v106
  s_cmp_eq_u32 s61, 0
  s_cbranch_scc0 L_NOFR3
  s_waitcnt lgkmcnt(8)
  ds_read_b64_tr_b16 v[70:71], v151 offset:2048
  ds_read_b64_tr_b16 v[72:73], v151 offset:2304
  ds_read_b64_tr_b16 v[74:75], v152 offset:2048
  ds_read_b64_tr_b16 v[76:77], v152 offset:2304
L_NOFR3:
L_H2DONE:
  v_cvt_pk_bf16_f32 v30, v30, v30
  v_lshlrev_b32 v30, 16, v30
  v_add_f32 v81, v30, v93
  v_cvt_pk_bf16_f32 v30, v81, v81
  s_cmp_ge_u32 s35, 14
  s_cbranch_scc1 L_FINAL
  ds_write_b16 v139, v30
  v_cmp_eq_u32 vcc, 1, v3
  v_cmp_eq_u32 s[46:47], 2, v3
  v_cmp_eq_u32 s[48:49], 3, v3
  s_waitcnt lgkmcnt(0)
  s_barrier
  ds_read_b128 v[10:13], v140
  ds_read_b128 v[14:17], v140 offset:64
  s_waitcnt lgkmcnt(1)
  v_mfma_f32_16x16x32_bf16 v[18:21], v[10:13], v[46:49], 0
  v_mfma_f32_16x16x32_bf16 v[22:25], v[10:13], v[50:53], 0
  v_mfma_f32_16x16x32_bf16 v[26:29], v[10:13], v[54:57], 0
  v_mfma_f32_16x16x32_bf16 v[30:33], v[10:13], v[58:61], 0
  v_mfma_f32_16x16x32_bf16 v[34:37], v[10:13], v[10:13], 0
  s_waitcnt lgkmcnt(0)
  v_mfma_f32_16x16x32_bf16 v[18:21], v[14:17], v[62:65], v[18:21]
  v_mfma_f32_16x16x32_bf16 v[22:25], v[14:17], v[66:69], v[22:25]
  v_mfma_f32_16x16x32_bf16 v[26:29], v[14:17], v[70:73], v[26:29]
  v_mfma_f32_16x16x32_bf16 v[30:33], v[14:17], v[74:77], v[30:33]
  v_mfma_f32_16x16x32_bf16 v[34:37], v[14:17], v[14:17], v[34:37]
  s_nop 7
  v_cndmask_b32 v18, v18, v22, vcc
  v_cndmask_b32 v19, v19, v23, vcc
  v_cndmask_b32 v18, v18, v26, s[46:47]
  v_cndmask_b32 v19, v19, v27, s[46:47]
  v_cndmask_b32 v18, v18, v30, s[48:49]
  v_cndmask_b32 v19, v19, v31, s[48:49]
  ds_write_b64 v145, v[18:19]
  s_mov_b64 exec, 1
  ds_write_b64 v147, v[34:35]
  s_mov_b64 exec, -1
  s_mov_b32 s45, 0x3d372713
  s_mov_b32 s50, 0x55555555
  s_mov_b32 s51, 0x55555555
  s_waitcnt vmcnt(0)
  ds_read_b64_tr_b16 v[46:47], v94
  ds_read_b64_tr_b16 v[48:49], v94 offset:512
  ds_read_b64_tr_b16 v[50:51], v148
  ds_read_b64_tr_b16 v[52:53], v148 offset:512
  ds_read_b64_tr_b16 v[54:55], v149
  ds_read_b64_tr_b16 v[56:57], v149 offset:512
  ds_read_b64_tr_b16 v[58:59], v150
  ds_read_b64_tr_b16 v[60:61], v150 offset:512
  s_waitcnt lgkmcnt(8)
  s_barrier
  s_waitcnt lgkmcnt(3)
  ds_read_b128 v[10:13], v141 offset:0
  ds_read_b128 v[14:17], v141 offset:16
  ds_read_b128 v[18:21], v141 offset:32
  ds_read_b128 v[22:25], v141 offset:48
  ds_read_b64 v[30:31], v146 offset:0
  ds_read_b64 v[32:33], v146 offset:512
  ds_read_b64 v[34:35], v146 offset:1024
  ds_read_b64 v[36:37], v146 offset:1536
  ds_read_b64 v[38:39], v146 offset:2048
  ds_read_b64 v[40:41], v146 offset:2560
  ds_read_b64 v[42:43], v146 offset:3072
  ds_read_b64 v[44:45], v146 offset:3584
  s_waitcnt lgkmcnt(8)
  v_add_f32 v10, v10, v12
  v_add_f32 v11, v11, v13
  v_add_f32 v14, v14, v16
  v_add_f32 v15, v15, v17
  v_add_f32 v18, v18, v20
  v_add_f32 v19, v19, v21
  v_add_f32 v22, v22, v24
  v_add_f32 v23, v23, v25
  v_add_f32 v10, v10, v14
  v_add_f32 v11, v11, v15
  v_add_f32 v18, v18, v22
  v_add_f32 v19, v19, v23
  v_add_f32 v10, v10, v18
  v_add_f32 v11, v11, v19
  v_mul_f32 v11, 0x3b000000, v11
  v_mul_f32 v10, 0x3b000000, v10
  v_fma_f32 v10, -v11, v11, v10
  v_max_f32 v10, 0, v10
  v_add_f32 v10, 0x3727c5ac, v10
  v_rsq_f32 v10, v10
  s_waitcnt lgkmcnt(0)
  v_add_f32 v30, v30, v32
  v_add_f32 v31, v31, v33
  v_add_f32 v34, v34, v36
  v_add_f32 v35, v35, v37
  v_add_f32 v38, v38, v40
  v_add_f32 v39, v39, v41
  v_add_f32 v42, v42, v44
  v_add_f32 v43, v43, v45
  v_add_f32 v30, v30, v34
  v_add_f32 v31, v31, v35
  v_add_f32 v38, v38, v42
  v_add_f32 v39, v39, v43
  v_add_f32 v30, v30, v38
  v_add_f32 v31, v31, v39
  v_fma_f32 v30, -v11, v31, v30
  v_mul_f32 v30, v30, v10
  v_mov_b32 v11, v30
  s_nop 1
  v_permlane32_swap_b32 v30, v11
  s_nop 1
  v_cvt_pk_bf16_f32 v10, v30, v30
  v_lshlrev_b32 v10, 16, v10
  v_cvt_pk_bf16_f32 v11, v11, v11
  v_lshlrev_b32 v11, 16, v11
  v_mul_f32 v12, v10, v10
  v_mul_f32 v12, v12, v10
  v_fma_f32 v12, v12, s45, v10
  v_mul_f32 v12, 0x40135761, v12
  v_exp_f32 v12, v12
  v_mul_f32 v13, 0.5, v10
  v_add_f32 v12, 1.0, v12
  v_rcp_f32 v12, v12
  s_nop 0
  v_fma_f32 v12, v12, -2.0, 2.0
  v_mul_f32 v12, v13, v12
  v_cvt_pk_bf16_f32 v12, v12, v12
  v_lshlrev_b32 v12, 16, v12
  v_mul_f32 v12, v12, v11
  v_cvt_pk_bf16_f32 v12, v12, v12
  ds_write_b16 v142, v12
  s_waitcnt lgkmcnt(0)
  ds_read_b128 v[10:13], v143
  s_waitcnt lgkmcnt(0)
  v_mfma_f32_16x16x32_bf16 v[62:65], v[10:13], v[46:49], 0
  v_mfma_f32_16x16x32_bf16 v[66:69], v[10:13], v[50:53], 0
  v_mfma_f32_16x16x32_bf16 v[70:73], v[10:13], v[54:57], 0
  v_mfma_f32_16x16x32_bf16 v[74:77], v[10:13], v[58:61], 0
  s_nop 7
  v_cndmask_b32 v62, v62, v66, vcc
  v_cndmask_b32 v62, v62, v70, s[46:47]
  v_cndmask_b32 v62, v62, v74, s[48:49]
  s_nop 1
  v_mov_b32_dpp v63, v62 quad_perm:[1,0,3,2] row_mask:0xf bank_mask:0xf
  s_nop 0
  v_cvt_pk_bf16_f32 v62, v62, v63
  s_mov_b64 exec, s[50:51]
  global_store_dword v144, v62, s[26:27] sc1
  s_mov_b64 exec, -1
  s_branch L_DONE
L_FINAL:
  v_lshlrev_b32 v81, 16, v30
  v_lshrrev_b32 v6, 5, v0
  v_lshlrev_b32 v7, 11, v6
  v_and_b32 v8, 31, v0
  v_lshl_add_u32 v7, v8, 2, v7
  s_lshl_b32 s41, s3, 5
  s_lshl_b32 s42, s34, 4
  s_add_u32 s41, s41, s42
  s_add_u32 s41, s41, s37
  s_lshl_b32 s41, s41, 10
  s_lshl_b32 s42, s28, 7
  s_add_u32 s41, s41, s42
  s_add_u32 s41, s41, 786432
  v_add_u32 v20, s41, v7
  v_add_u32 v21, 4096, v20
  v_add_u32 v22, 8192, v20
  v_lshlrev_b32 v9, 2, v8
  s_add_u32 s41, s41, 12288
  v_add_u32 v23, s41, v9
  v_lshlrev_b32 v6, 3, v8
  v_lshrrev_b32 v7, 5, v0
  v_lshl_add_u32 v6, v7, 2, v6
  s_lshl_b32 s41, s3, 9
  s_add_u32 s41, s41, 152064
  v_add_u32 v6, s41, v6
  s_lshl_b32 s41, s38, 10
  s_lshl_b32 s42, s28, 7
  s_add_u32 s41, s41, s42
  v_lshl_add_u32 v96, v2, 2, v3
  v_lshl_add_u32 v7, v96, 1, s41
  v_lshlrev_b32 v96, 2, v96
  v_add_u32 v96, 152064, v96
L_H3POLL:
  global_load_dword v30, v20, s[26:27] sc1
  global_load_dword v31, v21, s[26:27] sc1
  global_load_dword v32, v22, s[26:27] sc1
  global_load_dword v33, v23, s[26:27] sc1
  s_waitcnt vmcnt(0)
  v_max3_u32 v10, v30, v31, v32
  v_max_u32 v10, v10, v33
  v_cmp_eq_u32 vcc, -1, v10
  s_cbranch_vccz L_H3GOTA
  s_cmp_eq_u32 s44, 0
  s_cbranch_scc1 L_H3GOTA
  s_sub_u32 s44, s44, 1
  s_branch L_H3POLL
L_H3GOTA:
  v_cmp_gt_u32 vcc, 32, v0
  v_lshlrev_b32 v10, 16, v30
  v_and_b32 v11, 0xffff0000, v30
  v_cndmask_b32 v15, 0, v33, vcc
  v_lshlrev_b32 v12, 16, v31
  v_and_b32 v13, 0xffff0000, v31
  v_add_f32 v10, v10, v12
  v_add_f32 v11, v11, v13
  v_lshlrev_b32 v12, 16, v32
  v_and_b32 v13, 0xffff0000, v32
  v_add_f32 v10, v10, v12
  v_add_f32 v11, v11, v13
  v_lshlrev_b32 v12, 16, v15
  v_and_b32 v13, 0xffff0000, v15
  v_add_f32 v10, v10, v12
  v_add_f32 v11, v11, v13
L_H3DONE:
  s_nop 1
  v_permlane32_swap_b32 v10, v11
  s_nop 1
  v_add_f32 v10, v10, v11
  ds_write_b32 v6, v10
  s_waitcnt lgkmcnt(0)
  s_barrier
  s_cmp_lg_u32 s3, 0
  s_cbranch_scc1 L_DONE
  ds_read_b32 v10, v96 offset:0
  ds_read_b32 v11, v96 offset:512
  ds_read_b32 v12, v96 offset:1024
  ds_read_b32 v13, v96 offset:1536
  ds_read_b32 v14, v96 offset:2048
  ds_read_b32 v15, v96 offset:2560
  ds_read_b32 v16, v96 offset:3072
  ds_read_b32 v17, v96 offset:3584
  s_waitcnt lgkmcnt(0)
  v_add_f32 v10, v10, v11
  v_add_f32 v12, v12, v13
  v_add_f32 v14, v14, v15
  v_add_f32 v16, v16, v17
  v_add_f32 v10, v10, v12
  v_add_f32 v14, v14, v16
  v_add_f32 v10, v10, v14
  v_cvt_pk_bf16_f32 v10, v10, v10
  v_lshlrev_b32 v10, 16, v10
  v_add_f32 v10, v10, v81
  v_cvt_pk_bf16_f32 v10, v10, v10
  global_store_short v7, v10, s[22:23]
  s_cmp_lg_u32 s2, 112
  s_cbranch_scc1 L_DONE
  v_mov_b32 v10, s31
  v_mov_b32 v7, 0
  s_mov_b64 exec, 1
  global_store_dword v7, v10, s[26:27] sc1
  s_mov_b64 exec, -1
L_DONE:
  s_endpgm
L_HELPER:
  s_waitcnt lgkmcnt(0)
  s_lshl_b32 s41, s32, 3
  s_add_u32 s41, s41, s28
  s_lshl_b32 s41, s41, 21
  s_add_u32 s41, s41, 1572864
  s_add_u32 s46, s8, s41
  s_addc_u32 s47, s9, 0
  s_barrier
W_27:
  ds_read_b32 v90, v91 offset:0
  s_waitcnt lgkmcnt(0)
  v_readfirstlane_b32 s45, v90
  s_cmp_ge_u32 s45, 4
  s_cbranch_scc1 WD_28
  s_cmp_eq_u32 s44, 0
  s_cbranch_scc1 WD_28
  s_sub_u32 s44, s44, 1
  s_sleep 1
  s_branch W_27
WD_28:
  s_load_dword s48, s[46:47], 0
  s_waitcnt lgkmcnt(0)
  s_add_u32 s46, s12, 2097152
  s_addc_u32 s47, s13, 0
W_29:
  ds_read_b32 v90, v91 offset:0
  s_waitcnt lgkmcnt(0)
  v_readfirstlane_b32 s45, v90
  s_cmp_ge_u32 s45, 24
  s_cbranch_scc1 WD_30
  s_cmp_eq_u32 s44, 0
  s_cbranch_scc1 WD_30
  s_sub_u32 s44, s44, 1
  s_sleep 1
  s_branch W_29
WD_30:
  s_load_dword s48, s[12:13], 0
  s_load_dword s49, s[46:47], 0
  s_load_dword s50, s[16:17], 0
  s_load_dword s51, s[18:19], 0
  s_load_dword s52, s[20:21], 0
  s_load_dword s53, s[22:23], 0
  s_waitcnt lgkmcnt(0)
L_HEND:
  s_endpgm
L_LOADER:
  s_setprio 3
  v_mov_b32 v10, 0
  v_lshlrev_b32 v4, 2, v0
  v_add_u32 v4, 160768, v4
  ds_write_b32 v4, v10
  v_mov_b32 v10, 0x3f803f80
  v_and_b32 v4, 31, v0
  v_lshlrev_b32 v4, 2, v4
  v_add_u32 v4, 160384, v4
  ds_write_b32 v4, v10
  v_lshrrev_b32 v4, 3, v0
  v_and_b32 v5, 7, v0
  v_lshrrev_b32 v6, 1, v4
  v_and_b32 v6, 1, v6
  v_lshlrev_b32 v6, 1, v6
  v_xor_b32 v5, v5, v6
  v_lshlrev_b32 v5, 4, v5
  v_lshl_add_u32 v20, v4, 13, v5
  v_xor_b32 v21, 64, v20
  v_add_u32 v21, 64512, v21
  v_add_u32 v22, 129024, v20
  v_xor_b32 v23, 64, v20
  v_add_u32 v23, 193536, v23
  s_lshl_b32 s41, s28, 10
  s_lshl_b32 s42, s33, 7
  s_add_u32 s41, s41, s42
  s_lshl_b32 s42, s32, 20
  s_add_u32 s41, s41, s42
  v_mov_b32 v40, 0
  s_mov_b32 s40, 0
  s_mov_b32 s49, 0
  s_mov_b32 s45, 131072
  s_waitcnt lgkmcnt(0)
  s_add_u32 s46, s10, s41
  s_addc_u32 s47, s11, 0
  s_mov_b32 s48, 0
L_SWQ:
  s_mov_b32 m0, s45
  s_add_u32 s45, s45, 4096
  global_load_lds_dwordx4 v20, s[46:47] offset:0 nt
  global_load_lds_dwordx4 v21, s[46:47] offset:1024 nt
  global_load_lds_dwordx4 v22, s[46:47] offset:2048 nt
  global_load_lds_dwordx4 v23, s[46:47] offset:3072 nt
  s_add_u32 s46, s46, 262144
  s_addc_u32 s47, s47, 0
  s_add_u32 s40, s40, 1
  s_sub_u32 s41, s40, 6
  s_max_i32 s49, s49, s41
  v_mov_b32 v10, s49
  s_waitcnt vmcnt(24)
  ds_write_b32 v91, v10
  s_add_u32 s48, s48, 1
  s_cmp_lt_u32 s48, 4
  s_cbranch_scc1 L_SWQ
  s_waitcnt lgkmcnt(0)
  s_barrier
  v_lshlrev_b32 v4, 8, v3
  v_add_u32 v5, 0, v3
  v_xor_b32 v5, v5, v2
  v_lshl_add_u32 v24, v5, 4, v4
  v_add_u32 v5, 4, v3
  v_xor_b32 v5, v5, v2
  v_lshl_add_u32 v25, v5, 4, v4
  v_add_u32 v5, 8, v3
  v_xor_b32 v5, v5, v2
  v_lshl_add_u32 v26, v5, 4, v4
  v_add_u32 v5, 12, v3
  v_xor_b32 v5, v5, v2
  v_lshl_add_u32 v27, v5, 4, v4
  v_or_b32 v5, 0, v3
  v_lshlrev_b32 v5, 1, v5
  v_xor_b32 v5, v5, v2
  v_lshl_add_u32 v28, v5, 4, v4
  v_or_b32 v5, 4, v3
  v_lshlrev_b32 v5, 1, v5
  v_xor_b32 v5, v5, v2
  v_lshl_add_u32 v29, v5, 4, v4
  v_mov_b32 v50, v28
  v_mov_b32 v51, v28
  v_mov_b32 v52, v29
  v_mov_b32 v53, v29
  v_lshrrev_b32 v4, 3, v0
  v_and_b32 v5, 7, v0
  v_lshrrev_b32 v6, 1, v4
  v_and_b32 v6, 1, v6
  v_lshlrev_b32 v6, 1, v6
  v_xor_b32 v5, v5, v6
  v_lshlrev_b32 v5, 4, v5
  v_lshl_add_u32 v30, v4, 10, v5
  v_xor_b32 v31, 64, v30
  v_add_u32 v31, 7168, v31
  v_add_u32 v32, 14336, v30
  v_xor_b32 v33, 64, v30
  v_add_u32 v33, 21504, v33
  v_lshrrev_b32 v5, 5, v0
  v_lshlrev_b32 v5, 1, v5
  v_and_b32 v6, 3, v0
  v_xor_b32 v5, v5, v6
  v_lshrrev_b32 v4, 2, v0
  v_mul_u32_u24 v4, 3584, v4
  v_lshl_add_u32 v34, v5, 4, v4
  v_add_u32 v35, 56320, v34
  v_add_u32 v36, 112640, v34
  v_add_u32 v37, 168960, v34
  s_mul_i32 s41, s28, 7
  s_lshr_b32 s41, s41, 1
  s_lshl_b32 s41, s41, 7
  s_mul_i32 s42, s29, 57344
  s_add_u32 s41, s41, s42
  v_lshrrev_b32 v4, 3, v0
  v_mul_u32_u24 v4, 3584, v4
  v_and_b32 v5, 7, v0
  v_lshl_add_u32 v4, v5, 6, v4
  v_add_u32 v42, s41, v4
  v_add_u32 v43, 28672, v42
  s_mul_i32 s41, s28, 229376
  s_mul_i32 s42, s29, 7168
  s_add_u32 s41, s41, s42
  v_lshl_add_u32 v44, v0, 6, s41
  v_min_u32 v5, 47, v0
  v_lshl_add_u32 v45, v5, 6, s41
  v_add_u32 v45, 4096, v45
  s_mul_i32 s41, s28, 7
  s_lshr_b32 s41, s41, 1
  s_lshl_b32 s41, s41, 7
  s_mul_i32 s42, s29, 57344
  s_add_u32 s41, s41, s42
  v_lshrrev_b32 v4, 2, v0
  v_mul_u32_u24 v4, 3584, v4
  v_and_b32 v5, 3, v0
  v_lshl_add_u32 v4, v5, 7, v4
  v_add_u32 v47, s41, v4
  s_mul_i32 s41, s28, 229376
  s_mul_i32 s42, s29, 7168
  s_add_u32 s41, s41, s42
  v_min_u32 v5, 55, v0
  v_lshl_add_u32 v48, v5, 7, s41
  s_lshl_b32 s41, s32, 3
  s_add_u32 s41, s41, s28
  s_lshl_b32 s41, s41, 21
  s_mul_i32 s42, s33, 4096
  s_add_u32 s41, s41, s42
  s_add_u32 s50, s41, 1572864
  s_add_u32 s46, s6, s50
  s_addc_u32 s47, s7, 0
  s_mov_b32 s45, 0
  s_mov_b32 s48, 0
L_SK:
  s_mov_b32 m0, s45
  s_add_u32 s45, s45, 4096
  global_load_lds_dwordx4 v24, s[46:47] offset:0 nt
  global_load_lds_dwordx4 v25, s[46:47] offset:1024 nt
  global_load_lds_dwordx4 v26, s[46:47] offset:2048 nt
  global_load_lds_dwordx4 v27, s[46:47] offset:3072 nt
  s_add_u32 s46, s46, 32768
  s_addc_u32 s47, s47, 0
  s_add_u32 s40, s40, 1
  s_sub_u32 s41, s40, 6
  s_max_i32 s49, s49, s41
  v_mov_b32 v10, s49
  s_waitcnt vmcnt(24)
  ds_write_b32 v91, v10
  s_add_u32 s48, s48, 1
  s_cmp_lt_u32 s48, 16
  s_cbranch_scc1 L_SK
  s_add_u32 s46, s8, s50
  s_addc_u32 s47, s9, 0
  s_mov_b32 s45, 65536
  s_mov_b32 s48, 0
L_SV:
  s_mov_b32 m0, s45
  s_add_u32 s45, s45, 4096
  global_load_lds_dwordx4 v50, s[46:47] offset:0 nt
  global_load_lds_dwordx4 v51, s[46:47] offset:1024 nt
  global_load_lds_dwordx4 v52, s[46:47] offset:2048 nt
  global_load_lds_dwordx4 v53, s[46:47] offset:3072 nt
  s_add_u32 s46, s46, 32768
  s_addc_u32 s47, s47, 0
  s_add_u32 s40, s40, 1
  s_sub_u32 s41, s40, 7
  s_max_i32 s49, s49, s41
  v_mov_b32 v10, s49
  s_waitcnt vmcnt(28)
  ds_write_b32 v91, v10
  s_add_u32 s48, s48, 1
  s_cmp_lt_u32 s48, 16
  s_cbranch_scc1 L_SV
  ds_read_b32 v90, v91 offset:16
  s_waitcnt lgkmcnt(0)
  v_readfirstlane_b32 s41, v90
  s_cmp_ge_u32 s41, 8
  s_cbranch_scc1 L_POKA
  s_sub_u32 s41, s40, 6
  s_max_i32 s49, s49, s41
  v_mov_b32 v10, s49
  s_waitcnt vmcnt(24)
  ds_write_b32 v91, v10
  s_sub_u32 s41, s40, 5
  s_max_i32 s49, s49, s41
  v_mov_b32 v10, s49
  s_waitcnt vmcnt(20)
  ds_write_b32 v91, v10
  s_sub_u32 s41, s40, 4
  s_max_i32 s49, s49, s41
  v_mov_b32 v10, s49
  s_waitcnt vmcnt(16)
  ds_write_b32 v91, v10
  s_sub_u32 s41, s40, 3
  s_max_i32 s49, s49, s41
  v_mov_b32 v10, s49
  s_waitcnt vmcnt(12)
  ds_write_b32 v91, v10
  s_sub_u32 s41, s40, 2
  s_max_i32 s49, s49, s41
  v_mov_b32 v10, s49
  s_waitcnt vmcnt(8)
  ds_write_b32 v91, v10
  s_sub_u32 s41, s40, 1
  s_max_i32 s49, s49, s41
  v_mov_b32 v10, s49
  s_waitcnt vmcnt(4)
  ds_write_b32 v91, v10
  s_sub_u32 s41, s40, 0
  s_max_i32 s49, s49, s41
  v_mov_b32 v10, s49
  s_waitcnt vmcnt(0)
  ds_write_b32 v91, v10
W_31:
  ds_read_b32 v90, v91 offset:16
  s_waitcnt lgkmcnt(0)
  v_readfirstlane_b32 s41, v90
  s_cmp_ge_u32 s41, 8
  s_cbranch_scc1 WD_32
  s_cmp_eq_u32 s44, 0
  s_cbranch_scc1 WD_32
  s_sub_u32 s44, s44, 1
  s_sleep 1
  s_branch W_31
WD_32:
L_POKA:
  s_lshl_b32 s41, s28, 19
  s_lshr_b32 s42, s35, 3
  s_lshl_b32 s42, s42, 18
  s_add_u32 s41, s41, s42
  s_and_b32 s42, s35, 7
  s_lshl_b32 s42, s42, 7
  s_add_u32 s41, s41, s42
  s_add_u32 s46, s12, s41
  s_addc_u32 s47, s13, 0
  s_mov_b32 s45, 0
  s_mov_b32 s48, 0
L_SWO:
  s_mov_b32 m0, s45
  s_add_u32 s45, s45, 4096
  global_load_lds_dwordx4 v30, s[46:47] offset:0
  global_load_lds_dwordx4 v31, s[46:47] offset:1024
  global_load_lds_dwordx4 v32, s[46:47] offset:2048
  global_load_lds_dwordx4 v33, s[46:47] offset:3072
  s_add_u32 s46, s46, 32768
  s_addc_u32 s47, s47, 0
  s_add_u32 s48, s48, 1
  s_cmp_lt_u32 s48, 8
  s_cbranch_scc1 L_SWO
  s_max_i32 s49, s49, 30
  v_mov_b32 v10, s49
  s_waitcnt vmcnt(56)
  ds_write_b32 v91, v10
  s_max_i32 s49, s49, 31
  v_mov_b32 v10, s49
  s_waitcnt vmcnt(52)
  ds_write_b32 v91, v10
  s_max_i32 s49, s49, 32
  v_mov_b32 v10, s49
  s_waitcnt vmcnt(48)
  ds_write_b32 v91, v10
  s_max_i32 s49, s49, 33
  v_mov_b32 v10, s49
  s_waitcnt vmcnt(44)
  ds_write_b32 v91, v10
  s_max_i32 s49, s49, 34
  v_mov_b32 v10, s49
  s_waitcnt vmcnt(40)
  ds_write_b32 v91, v10
  s_max_i32 s49, s49, 35
  v_mov_b32 v10, s49
  s_waitcnt vmcnt(36)
  ds_write_b32 v91, v10
  s_max_i32 s49, s49, 36
  v_mov_b32 v10, s49
  s_waitcnt vmcnt(32)
  ds_write_b32 v91, v10
W_33:
  ds_read_b32 v90, v91 offset:24
  s_waitcnt lgkmcnt(0)
  v_readfirstlane_b32 s41, v90
  s_cmp_ge_u32 s41, 8
  s_cbranch_scc1 WD_34
  s_cmp_eq_u32 s44, 0
  s_cbranch_scc1 WD_34
  s_sub_u32 s44, s44, 1
  s_branch W_33
WD_34:
  global_load_dword v46, v47, s[16:17]
  global_load_dword v46, v47, s[18:19]
  global_load_dword v46, v48, s[20:21]
  v_mov_b32 v10, 44
  s_waitcnt vmcnt(3)
  ds_write_b32 v91, v10
  s_waitcnt vmcnt(0) lgkmcnt(0)
L_END:
  s_endpgm
L_CODE_END:
.section .rodata,"a"
.p2align 6
.amdhsa_kernel sequential_preLN__sliding_block_cached__geglu_ffn__decode_kernel
  .amdhsa_next_free_vgpr 160
  .amdhsa_next_free_sgpr 102
  .amdhsa_accum_offset 160
  .amdhsa_group_segment_fixed_size 0
  .amdhsa_kernarg_size 96
  .amdhsa_user_sgpr_count 2
  .amdhsa_user_sgpr_kernarg_segment_ptr 1
  .amdhsa_system_sgpr_workgroup_id_x 1
.end_amdhsa_kernel
.text
```
